```python
import torch

def _softmax(x, axis=-1):
    return torch.softmax(x, dim=axis)
def _gelu(x):
    return torch.nn.functional.gelu(x, approximate="tanh")
def _silu(x):
    return torch.nn.functional.silu(x)
def _sigmoid(x):
    return torch.sigmoid(x)
def _layernorm(x, axis=-1, eps=1e-5):
    m = x.mean(dim=axis, keepdim=True)
    v = x.var(dim=axis, keepdim=True, unbiased=False)
    return (x - m) / torch.sqrt(v + eps)
def _scatter_add(tgt, idx, src, axis=0):
    return tgt.clone().index_add_(axis, idx, src)
def _segment_sum(src, seg, n):
    out = torch.zeros((n,) + src.shape[1:], dtype=src.dtype)
    return out.index_add_(0, seg, src)
def _pad(x, pw):
    flat = tuple(v for pair in reversed(pw) for v in pair)
    return torch.nn.functional.pad(x, flat)

kernel_name = 'standalone__paged_block_table_kv_pagedattention__decode'

def setup_inputs():

    _w = (lambda a: (lambda t: t.to(torch.bfloat16) if t.is_floating_point() else t)(torch.as_tensor(a)))
    B, Hq, Hkv, Sq, Skv, D = 4, 32, 8, 1, 4096, 128
    bs = 16
    nbps = max(1, Skv // bs)
    num_phys = B * nbps + 4
    bt = torch.randperm(num_phys)[: B * nbps].reshape(B, nbps).to(torch.int64)
    cl = (nbps * bs - (torch.arange(1, B + 1, dtype=torch.int64) * 2654435761) % max(1, nbps * bs // 2)).to(torch.int64)
    return {
        "q": _w((lambda *s: torch.randn(*s, dtype=torch.bfloat16) * 0.8)(B, Hq, Sq, D)),
        "k_cache": _w((lambda *s: torch.randn(*s, dtype=torch.bfloat16) * 0.8)(num_phys, bs, Hkv, D)),
        "v_cache": _w((lambda *s: torch.randn(*s, dtype=torch.bfloat16) * 0.05)(num_phys, bs, Hkv, D)),
        "block_table": _w(bt),
        "context_lens": _w(cl),
    }

def reference(q, k_cache, v_cache, block_table, context_lens):
    B, Hq, Sq, D = q.shape
    bs = k_cache.shape[1]
    Hkv = k_cache.shape[2]
    nbps = block_table.shape[1]
    Skv = nbps * bs
    bt = block_table.reshape(-1)
    k = (lambda x, *d: x.permute(*d))(k_cache[bt].reshape(B, Skv, Hkv, D), 0, 2, 1, 3)
    v = (lambda x, *d: x.permute(*d))(v_cache[bt].reshape(B, Skv, Hkv, D), 0, 2, 1, 3)
    g = Hq // Hkv
    qg = q.reshape(B, Hkv, g, Sq, D)
    scores = torch.einsum("bhgqd,bhkd->bhgqk", qg, k) * (D ** -0.5)
    pos = torch.arange(Skv)
    msk = pos[None, :] < context_lens[:, None]
    scores = torch.where(msk[:, None, None, None, :], scores, -1e9)
    p = _softmax(scores, axis=-1)
    out = torch.einsum("bhgqk,bhkd->bhgqd", p, v)
    return out.reshape(B, Hq, Sq, D)
```

```asm
; @launch grid=(256,1,1) block=(512,1,1) lds=144640
.amdgcn_target "amdgcn-amd-amdhsa--gfx950"
.text
.globl standalone__paged_block_table_kv_pagedattention__decode_kernel
.p2align 8
.type standalone__paged_block_table_kv_pagedattention__decode_kernel,@function
standalone__paged_block_table_kv_pagedattention__decode_kernel:
    s_load_dwordx16 s[56:71], s[0:1], 0
    v_readfirstlane_b32 s3, v0
    s_cmp_ge_u32 s2, 256
    s_cbranch_scc1 L_end
    s_lshl_b32 s29, s2, 3
    v_and_b32 v1, 63, v0
    s_and_b32 s29, s29, 32
    s_lshr_b32 s42, s2, 3
    s_add_u32 s29, s29, s42
    s_lshr_b32 s28, s3, 6
    s_mov_b32 s43, 1579763
    s_mov_b32 s48, 0x0
    s_cmp_ge_u32 s29, 19
    s_cselect_b32 s43, 1492205, s43
    s_cselect_b32 s48, 0x44f6269, s48
    s_cmp_ge_u32 s29, 32
    s_cselect_b32 s43, 1557444, s43
    s_cselect_b32 s48, 0xff078780, s48
    s_cmp_ge_u32 s29, 49
    s_cselect_b32 s43, 1529174, s43
    s_cselect_b32 s48, 0xff88aa8a, s48
    s_mul_i32 s42, s29, s43
    s_add_u32 s48, s48, s42
    s_add_u32 s49, s48, s43
    s_lshr_b32 s48, s48, 16
    s_sub_u32 s42, s48, s28
    s_and_b32 s42, s42, 1
    s_add_u32 s48, s48, s42
    s_andn2_b32 s42, s28, 1
    s_add_u32 s48, s48, s42
    s_andn2_b32 s42, s48, 1
    s_lshl_b32 s42, s42, 1
    v_lshl_add_u32 v2, v1, 4, s42
    s_mov_b64 exec, 0xff
    s_waitcnt lgkmcnt(0)
    global_load_dword v8, v2, s[62:63]
    s_load_dwordx4 s[52:55], s[64:65], 0
    s_mov_b64 exec, -1
    s_and_b32 s30, s2, 3
    v_lshlrev_b32 v9, 4, v0
    s_lshl_b32 s44, s30, 6
    v_and_b32 v9, 0xfff, v9
    s_add_u32 s44, s44, s29
    s_lshl_b32 s44, s44, 12
    s_mov_b64 s[24:25], s[70:71]
    s_mov_b32 s26, 0x200000
    s_mov_b32 s27, 0x20000
    buffer_load_dwordx4 v[140:143], v9, s[24:27], s44 offen sc1
    v_lshrrev_b32 v16, 4, v1
    s_and_b32 s42, s28, 1
    v_and_b32 v4, 15, v0
    s_lshl_b32 s31, s30, 1
    v_xor_b32 v5, v4, v16
    s_add_u32 s31, s31, s42
    v_lshlrev_b32 v5, 4, v5
    s_lshl_b32 s31, s31, 8
    v_lshl_add_u32 v52, v16, 11, v5
    s_lshl_b32 s38, s28, 14
    v_add_u32 v52, s31, v52
    s_mov_b64 s[8:9], s[58:59]
    v_lshl_add_u32 v60, v4, 8, v5
    s_mov_b32 s10, 0x2020000
    v_xor_b32 v53, 64, v52
    s_mov_b32 s11, 0x20000
    v_xor_b32 v54, 0x80, v52
    s_mov_b32 m0, s38
    v_xor_b32 v55, 0xc0, v52
    v_add_u32 v53, 7168, v53
    v_add_u32 v54, 14336, v54
    v_add_u32 v55, 21504, v55
    s_lshr_b32 s32, s48, 9
    v_and_b32 v6, 3, v0
    s_lshl_b32 s50, s32, 13
    s_lshl_b32 s42, s31, 2
    s_add_u32 s42, s42, s50
    s_lshr_b32 s49, s49, 16
    v_lshl_add_u32 v11, v1, 4, s42
    s_sub_i32 s36, s49, s48
    s_add_i32 s36, s36, 7
    s_ashr_i32 s36, s36, 3
    s_mov_b32 s73, 0
    s_setprio 3
    s_waitcnt vmcnt(1)
L_have:
    v_readlane_b32 s40, v8, 0
    v_readlane_b32 s43, v8, 1
    s_lshl_b32 s40, s40, 15
    buffer_load_dwordx4 v52, s[8:11], s40 offen nt lds
    buffer_load_dwordx4 v53, s[8:11], s40 offen offset:1024 nt lds
    buffer_load_dwordx4 v54, s[8:11], s40 offen offset:2048 nt lds
    buffer_load_dwordx4 v55, s[8:11], s40 offen offset:3072 nt lds
    s_add_u32 s39, s38, 0x2000
    s_cmp_lg_u32 s73, 0
    s_cbranch_scc1 L_c3
    s_waitcnt lgkmcnt(0)
    s_xor_b32 s42, s52, 3663
    s_xor_b32 s72, s53, 3230
    s_or_b32 s42, s42, s72
    s_xor_b32 s72, s54, 2797
    s_or_b32 s42, s42, s72
    s_xor_b32 s72, s55, 2364
    s_or_b32 s42, s42, s72
    s_cbranch_scc1 L_general
L_c3:
    s_lshl_b32 s42, s28, 10
    s_add_u32 s17, s42, 136448
    s_mov_b32 m0, s17
    v_lshlrev_b32 v5, 1, v16
    v_xor_b32 v5, v4, v5
    s_mov_b64 s[12:13], s[60:61]
    v_lshlrev_b32 v5, 4, v5
    s_mov_b32 s14, s10
    v_lshl_add_u32 v56, v16, 11, v5
    s_mov_b32 s15, 0x20000
    v_add_u32 v56, s31, v56
    v_xor_b32 v57, 0x80, v56
    v_add_u32 v58, 14336, v56
    v_add_u32 v59, 21504, v57
    v_add_u32 v57, 7168, v57
    global_load_lds_dwordx4 v11, s[56:57]
    s_mov_b32 m0, s39
    s_nop 0
    buffer_load_dwordx4 v56, s[12:15], s40 offen nt lds
    buffer_load_dwordx4 v57, s[12:15], s40 offen offset:1024 nt lds
    buffer_load_dwordx4 v58, s[12:15], s40 offen offset:2048 nt lds
    buffer_load_dwordx4 v59, s[12:15], s40 offen offset:3072 nt lds
    s_cmp_lt_i32 s36, 2
    s_cbranch_scc1 L_issued
    s_add_u32 s42, s38, 0x1000
    s_mov_b32 m0, s42
    s_lshl_b32 s43, s43, 15
    s_add_u32 s42, s39, 0x1000
    buffer_load_dwordx4 v52, s[8:11], s43 offen nt lds
    buffer_load_dwordx4 v53, s[8:11], s43 offen offset:1024 nt lds
    buffer_load_dwordx4 v54, s[8:11], s43 offen offset:2048 nt lds
    buffer_load_dwordx4 v55, s[8:11], s43 offen offset:3072 nt lds
    s_mov_b32 m0, s42
    s_nop 0
    buffer_load_dwordx4 v56, s[12:15], s43 offen nt lds
    buffer_load_dwordx4 v57, s[12:15], s43 offen offset:1024 nt lds
    buffer_load_dwordx4 v58, s[12:15], s43 offen offset:2048 nt lds
    buffer_load_dwordx4 v59, s[12:15], s43 offen offset:3072 nt lds
L_issued:
    s_setprio 0
    s_cmp_lg_u32 s73, 0
    s_cbranch_scc1 L_checked
    s_lshl_b32 s43, s32, 3
    s_or_b32 s43, s43, 0x80000
    s_bfe_u32 s33, 0x13312000, s43
    s_bfe_u32 s34, 0xd0f1113, s43
    s_bfe_u32 s35, 0x94afcae5, s43
    s_bfe_u32 s43, 0x4030201, s43
    s_lshl_b32 s35, s35, 4
    s_sub_u32 s35, s35, s43
    s_bfe_u32 s48, s48, 0x80001
    s_lshl_b32 s48, s48, 4
    s_sub_i32 s35, s35, s48
    s_mov_b32 s49, 0xdd800000
L_checked:
    v_add_u32 v60, s38, v60
    s_mov_b64 s[20:21], s[66:67]
    s_lshl_b32 s83, s30, 2
    s_add_u32 s83, s83, s32
    s_lshl_b32 s83, s83, 7
    s_add_u32 s83, s83, 3145740
    s_load_dword s80, s[24:25], s83
    v_lshrrev_b32 v2, 2, v4
    v_lshl_add_u32 v2, v16, 2, v2
    v_and_b32 v5, 7, v2
    v_lshlrev_b32 v5, 5, v5
    v_lshl_add_u32 v5, v2, 8, v5
    v_lshl_add_u32 v5, v6, 3, v5
    v_add_u32 v64, s39, v5
    v_xor_b32 v65, 32, v64
    v_xor_b32 v66, 64, v64
    v_xor_b32 v67, 96, v64
    v_xor_b32 v68, 128, v64
    v_xor_b32 v69, 160, v64
    v_xor_b32 v70, 192, v64
    v_xor_b32 v71, 224, v64
    v_xor_b32 v61, 64, v60
    v_xor_b32 v62, 128, v60
    v_xor_b32 v63, 192, v60
    v_lshl_add_u32 v17, v1, 4, s38
    v_lshl_add_u32 v34, v1, 3, s38
    s_and_b32 s42, s28, 1
    s_lshl_b32 s42, s42, 14
    v_lshl_add_u32 v150, v1, 3, s42
    v_add_u32 v151, 0x10000, v150
    s_and_b32 s43, s28, 2
    s_lshl_b32 s43, s43, 9
    s_add_u32 s42, s42, s43
    v_lshl_add_u32 v18, v1, 4, s42
    v_add_u32 v35, 0x10000, v18
    v_mov_b32 v15, s49
    s_mov_b32 s41, 0x3e0293ee
    v_mov_b32 v12, 0xdd800000
    v_mul_f32 v13, s41, v12
    v_mov_b32 v98, 0x3f803f80
    v_mov_b32 v99, 0x3f803f80
    v_mov_b32 v32, 0
    v_mov_b32 v33, v13
    v_mov_b32 v20, 0
    v_mov_b32 v21, 0
    v_mov_b32 v22, 0
    v_mov_b32 v23, 0
    v_mov_b32 v24, 0
    v_mov_b32 v25, 0
    v_mov_b32 v26, 0
    v_mov_b32 v27, 0
    v_mov_b32 v28, 0
    v_mov_b32 v29, 0
    v_mov_b32 v30, 0
    v_mov_b32 v31, 0
    v_mov_b32 v88, 0
    v_mov_b32 v89, 0
    v_mov_b32 v90, 0
    v_mov_b32 v91, 0
    v_mov_b32 v92, 0
    v_mov_b32 v93, 0
    v_mov_b32 v94, 0
    v_mov_b32 v95, 0
    s_getreg_b32 s74, hwreg(HW_REG_XCC_ID, 0, 3)
    s_lshl_b32 s42, s30, 6
    s_add_u32 s42, s42, s33
    s_lshl_b32 s42, s42, 12
    s_add_u32 s4, s24, s42
    s_addc_u32 s5, s25, 0
    s_mov_b32 s6, 0x200000
    s_mov_b32 s7, 0x20000
    s_sub_u32 s33, s29, s33
    s_add_u32 s42, s33, s34
    s_and_b32 s33, s33, 15
    s_cmp_ge_u32 s28, 4
    s_cselect_b32 s33, s42, s33
    s_lshr_b32 s23, s33, 4
    s_lshl_b32 s45, s34, 1
    s_and_b32 s46, s28, 3
    s_lshl_b32 s46, s46, 10
    s_mov_b32 s76, 0
    s_mov_b32 s37, 2
    v_lshrrev_b32 v2, 2, v1
    v_lshlrev_b32 v19, 4, v6
    v_lshl_add_u32 v19, v2, 12, v19
    v_cmp_gt_u32_e64 s[60:61], s34, v2
    v_add_u32 v2, 16, v2
    v_cmp_gt_u32_e64 s[62:63], s34, v2
    v_add_u32 v2, 16, v2
    v_cmp_gt_u32_e64 s[64:65], s34, v2
    v_add_u32 v2, 16, v2
    v_cmp_gt_u32_e64 s[66:67], s34, v2
    v_and_b32 v10, 2, v16
    v_and_b32 v2, 1, v16
    v_lshl_add_u32 v10, v2, 2, v10
    v_lshl_add_u32 v10, v6, 8, v10
    s_lshl_b32 s42, s31, 2
    s_add_u32 s50, s50, s42
    s_and_b32 s42, s28, 2
    s_lshl_b32 s42, s42, 4
    s_add_u32 s50, s50, s42
    v_add_u32 v10, s50, v10
    v_lshlrev_b32 v16, 2, v16
    s_waitcnt lgkmcnt(0)
    s_add_u32 s80, s80, 0x9e3779b8
    s_andn2_b32 s51, s80, 7
    s_or_b32 s51, s51, s74
    s_xor_b32 s74, s80, s51
    v_mov_b32 v139, s51
    v_mov_b32 v120, 0
    v_mov_b32 v121, 0
    v_mov_b32 v122, 0xff7fffff
    v_mov_b32 v123, s51
    v_mov_b32 v124, 0
    v_mov_b32 v125, 0
    v_mov_b32 v126, 0xff7fffff
    v_mov_b32 v127, s51
    v_mov_b32 v128, 0
    v_mov_b32 v129, 0
    v_mov_b32 v130, 0xff7fffff
    v_mov_b32 v131, s51
    v_mov_b32 v132, 0
    v_mov_b32 v133, 0
    v_mov_b32 v134, 0xff7fffff
    v_mov_b32 v135, s51
    s_mov_b32 s73, 0
    s_branch L_task
L_taskback:
    s_cmp_lt_i32 s36, 1
    s_cbranch_scc1 L_done
    v_lshlrev_b32 v11, 2, v16
    v_lshl_add_u32 v11, v6, 8, v11
    v_add_u32 v11, s17, v11
    s_waitcnt vmcnt(12)
    s_cmp_gt_i32 s36, 1
    s_cbranch_scc1 L_q
    s_waitcnt vmcnt(4)
L_q:
    ds_read_b128 v[72:75], v11 offset:0
    ds_read_b128 v[76:79], v11 offset:64
    ds_read_b128 v[80:83], v11 offset:128
    ds_read_b128 v[84:87], v11 offset:192
    s_branch L_kready
L_loop:
    s_waitcnt vmcnt(12)
    s_cmp_gt_i32 s36, 1
    s_cbranch_scc1 L_kready
    s_waitcnt vmcnt(4)
L_kready:
    ds_read_b128 v[36:39], v60
    ds_read_b128 v[40:43], v61
    ds_read_b128 v[44:47], v62
    ds_read_b128 v[48:51], v63
    v_readlane_b32 s40, v8, s37
    s_mov_b32 m0, s38
    s_lshl_b32 s40, s40, 15
    s_waitcnt lgkmcnt(3)
    v_mfma_f32_16x16x32_bf16 v[100:103], v[36:39], v[72:75], 0
    s_waitcnt lgkmcnt(2)
    v_mfma_f32_16x16x32_bf16 v[100:103], v[40:43], v[76:79], v[100:103]
    s_waitcnt lgkmcnt(1)
    v_mfma_f32_16x16x32_bf16 v[100:103], v[44:47], v[80:83], v[100:103]
    s_waitcnt lgkmcnt(0)
    v_mfma_f32_16x16x32_bf16 v[100:103], v[48:51], v[84:87], v[100:103]
    s_cmp_lt_i32 s36, 3
    s_cbranch_scc1 L_nok
    buffer_load_dwordx4 v52, s[8:11], s40 offen nt lds
    buffer_load_dwordx4 v53, s[8:11], s40 offen offset:1024 nt lds
    buffer_load_dwordx4 v54, s[8:11], s40 offen offset:2048 nt lds
    buffer_load_dwordx4 v55, s[8:11], s40 offen offset:3072 nt lds
L_nok:
    v_xor_b32 v60, 0x1000, v60
    v_xor_b32 v61, 0x1000, v61
    v_xor_b32 v62, 0x1000, v62
    v_xor_b32 v63, 0x1000, v63
    s_xor_b32 s38, s38, 0x1000
    s_mov_b32 m0, s39
    s_nop 1
    s_cmp_ge_i32 s35, 16
    s_cbranch_scc1 L_nomask
    v_subrev_u32 v2, s35, v16
    v_cmp_gt_i32_e64 s[52:53], 0, v2
    v_cmp_gt_i32_e64 s[54:55], -1, v2
    v_cmp_gt_i32_e64 s[56:57], -2, v2
    v_cmp_gt_i32_e64 s[58:59], -3, v2
    v_cndmask_b32_e64 v100, v15, v100, s[52:53]
    v_cndmask_b32_e64 v101, v15, v101, s[54:55]
    v_cndmask_b32_e64 v102, v15, v102, s[56:57]
    v_cndmask_b32_e64 v103, v15, v103, s[58:59]
L_nomask:
    v_max3_f32 v12, v100, v101, v12
    v_max3_f32 v12, v102, v103, v12
    v_mov_b32 v2, v12
    s_nop 1
    v_permlane16_swap_b32 v12, v2
    v_max_f32 v12, v12, v2
    v_mov_b32 v2, v12
    s_nop 1
    v_permlane32_swap_b32 v12, v2
    v_max_f32 v12, v12, v2
    v_mul_f32 v33, s41, v12
    v_sub_f32 v14, v13, v33
    v_fma_f32 v100, v100, s41, -v33
    v_fma_f32 v101, v101, s41, -v33
    v_fma_f32 v102, v102, s41, -v33
    v_fma_f32 v103, v103, s41, -v33
    v_exp_f32 v14, v14
    v_exp_f32 v100, v100
    v_exp_f32 v101, v101
    v_exp_f32 v102, v102
    v_exp_f32 v103, v103
    v_mov_b32 v13, v33
    v_cvt_pk_bf16_f32 v96, v100, v101
    v_cvt_pk_bf16_f32 v97, v102, v103
    v_mul_f32 v28, v14, v28
    v_mul_f32 v20, v14, v20
    v_mul_f32 v21, v14, v21
    v_mul_f32 v22, v14, v22
    v_mul_f32 v23, v14, v23
    v_mfma_f32_16x16x16_bf16 v[28:31], v[98:99], v[96:97], v[28:31]
    v_mul_f32 v24, v14, v24
    v_mul_f32 v25, v14, v25
    v_mul_f32 v26, v14, v26
    v_mul_f32 v27, v14, v27
    v_mov_b32_dpp v88, v96 quad_perm:[0,1,2,3] row_mask:0xf bank_mask:0x1
    v_mov_b32_dpp v89, v97 quad_perm:[0,1,2,3] row_mask:0xf bank_mask:0x1
    v_mov_b32_dpp v90, v96 quad_perm:[0,1,2,3] row_mask:0xf bank_mask:0x2
    v_mov_b32_dpp v91, v97 quad_perm:[0,1,2,3] row_mask:0xf bank_mask:0x2
    v_mov_b32_dpp v92, v96 quad_perm:[0,1,2,3] row_mask:0xf bank_mask:0x4
    v_mov_b32_dpp v93, v97 quad_perm:[0,1,2,3] row_mask:0xf bank_mask:0x4
    v_mov_b32_dpp v94, v96 quad_perm:[0,1,2,3] row_mask:0xf bank_mask:0x8
    v_mov_b32_dpp v95, v97 quad_perm:[0,1,2,3] row_mask:0xf bank_mask:0x8
    v_mov_b32 v32, v28
    s_waitcnt vmcnt(12)
    s_cmp_gt_i32 s36, 2
    s_cbranch_scc1 L_vready
    s_waitcnt vmcnt(8)
    s_cmp_gt_i32 s36, 1
    s_cbranch_scc1 L_vready
    s_waitcnt vmcnt(0)
L_vready:
    ds_read_b64_tr_b16 v[104:105], v64
    ds_read_b64_tr_b16 v[106:107], v66
    ds_read_b64_tr_b16 v[108:109], v68
    ds_read_b64_tr_b16 v[110:111], v70
    ds_read_b64_tr_b16 v[112:113], v65
    ds_read_b64_tr_b16 v[114:115], v67
    ds_read_b64_tr_b16 v[116:117], v69
    ds_read_b64_tr_b16 v[118:119], v71
    s_cmp_lt_i32 s36, 2
    s_waitcnt lgkmcnt(6)
    v_mfma_f32_16x16x32_bf16 v[20:23], v[104:107], v[88:91], v[20:23]
    s_waitcnt lgkmcnt(4)
    v_mfma_f32_16x16x32_bf16 v[20:23], v[108:111], v[92:95], v[20:23]
    s_waitcnt lgkmcnt(2)
    v_mfma_f32_16x16x32_bf16 v[24:27], v[112:115], v[88:91], v[24:27]
    s_waitcnt lgkmcnt(0)
    v_mfma_f32_16x16x32_bf16 v[24:27], v[116:119], v[92:95], v[24:27]
    s_cbranch_scc1 L_last
    s_cmp_lt_i32 s36, 3
    s_cbranch_scc1 L_nov
    buffer_load_dwordx4 v56, s[12:15], s40 offen nt lds
    buffer_load_dwordx4 v57, s[12:15], s40 offen offset:1024 nt lds
    buffer_load_dwordx4 v58, s[12:15], s40 offen offset:2048 nt lds
    buffer_load_dwordx4 v59, s[12:15], s40 offen offset:3072 nt lds
L_nov:
    v_xor_b32 v64, 0x1000, v64
    v_xor_b32 v65, 0x1000, v65
    v_xor_b32 v66, 0x1000, v66
    v_xor_b32 v67, 0x1000, v67
    v_xor_b32 v68, 0x1000, v68
    v_xor_b32 v69, 0x1000, v69
    v_xor_b32 v70, 0x1000, v70
    v_xor_b32 v71, 0x1000, v71
    s_xor_b32 s39, s39, 0x1000
    s_sub_i32 s36, s36, 1
    s_sub_i32 s35, s35, 64
    s_add_u32 s37, s37, 1
    s_branch L_loop
L_last:
L_done:
    ds_write_b64 v34, v[32:33] offset:2048
    s_mov_b32 s42, 0x42700000
    s_mov_b32 s22, 0xffff0000
    ds_write_b128 v17, v[20:23]
    s_mov_b32 s47, 0x10000
    s_mov_b32 s75, 0x80000018
    s_mov_b32 s77, 0
    ds_write_b128 v17, v[24:27] offset:1024
    s_cmp_lg_u32 s23, 0
    s_waitcnt lgkmcnt(0)
    s_barrier
    s_cbranch_scc1 L_exit
    ds_read_b64 v[104:105], v150 offset:2048
    ds_read_b64 v[106:107], v150 offset:34816
    ds_read_b64 v[108:109], v151 offset:2048
    ds_read_b64 v[110:111], v151 offset:34816
    ds_read_b128 v[36:39], v18
    ds_read_b128 v[40:43], v18 offset:32768
    ds_read_b128 v[44:47], v35
    ds_read_b128 v[48:51], v35 offset:32768
    s_waitcnt lgkmcnt(4)
    v_max3_f32 v2, v105, v107, v109
    v_max_f32 v2, v2, v111
    v_sub_f32 v105, v105, v2
    v_sub_f32 v107, v107, v2
    v_sub_f32 v109, v109, v2
    v_sub_f32 v111, v111, v2
    v_exp_f32 v105, v105
    v_exp_f32 v107, v107
    v_exp_f32 v109, v109
    v_exp_f32 v111, v111
    v_mul_f32 v3, v104, v105
    v_fmac_f32 v3, v106, v107
    v_fmac_f32 v3, v108, v109
    v_fmac_f32 v3, v110, v111
    v_max_f32 v3, 0x00800000, v3
    v_rcp_f32 v104, v3
    v_log_f32 v3, v3
    s_cmp_ge_u32 s28, 4
    s_cbranch_scc1 L_pub
    s_waitcnt lgkmcnt(0)
    v_pk_mul_f32 v[72:73], v[36:37], v[104:105] op_sel:[0,1] op_sel_hi:[1,1]
    v_pk_mul_f32 v[74:75], v[38:39], v[104:105] op_sel:[0,1] op_sel_hi:[1,1]
    v_pk_fma_f32 v[72:73], v[40:41], v[106:107], v[72:73] op_sel:[0,1,0] op_sel_hi:[1,1,1]
    v_pk_fma_f32 v[74:75], v[42:43], v[106:107], v[74:75] op_sel:[0,1,0] op_sel_hi:[1,1,1]
    v_pk_fma_f32 v[72:73], v[44:45], v[108:109], v[72:73] op_sel:[0,1,0] op_sel_hi:[1,1,1]
    v_pk_fma_f32 v[74:75], v[46:47], v[108:109], v[74:75] op_sel:[0,1,0] op_sel_hi:[1,1,1]
    v_pk_fma_f32 v[72:73], v[48:49], v[110:111], v[72:73] op_sel:[0,1,0] op_sel_hi:[1,1,1]
    v_pk_fma_f32 v[74:75], v[50:51], v[110:111], v[74:75] op_sel:[0,1,0] op_sel_hi:[1,1,1]
    v_pk_mul_f32 v[72:73], v[72:73], v[104:105] op_sel:[0,0] op_sel_hi:[1,0]
    v_pk_mul_f32 v[74:75], v[74:75], v[104:105] op_sel:[0,0] op_sel_hi:[1,0]
    v_add_f32 v138, v2, v3
    v_cvt_pk_bf16_f32 v136, v72, v73
    v_cvt_pk_bf16_f32 v137, v74, v75
    buffer_store_dwordx4 v[136:139], v9, s[24:27], s44 offen
L_pub:
    v_add_f32 v148, v2, v3
    v_add_f32 v149, s42, v148
L_poll:
    s_mov_b64 exec, s[60:61]
    buffer_load_dwordx4 v[120:123], v19, s[4:7], s68 offen sc1
    s_mov_b64 exec, s[62:63]
    s_cbranch_execz L_pe
    buffer_load_dwordx4 v[124:127], v19, s[4:7], s69 offen sc1
    s_mov_b64 exec, s[64:65]
    s_cbranch_execnz L_pmore
L_pe:
    s_mov_b64 exec, -1
    s_sub_i32 s75, s75, 1
    s_cbranch_scc1 L_late
    v_add_u32 v4, s72, v10
    s_waitcnt vmcnt(0) lgkmcnt(0)
    v_cmp_ne_u32 vcc, s51, v123
    v_cmp_ne_u32_e64 s[52:53], s51, v127
    v_max_f32 v2, v122, v126
    s_or_b64 vcc, vcc, s[52:53]
    s_cbranch_vccnz L_poll
    v_cmp_lt_f32 vcc, v149, v2
    s_cbranch_vccnz L_slow
L_got:
    v_sub_f32 v112, v122, v148
    v_sub_f32 v113, v126, v148
    v_exp_f32 v112, v112
    v_exp_f32 v113, v113
    v_lshlrev_b32 v36, 16, v120
    v_and_b32 v37, s22, v120
    v_lshlrev_b32 v38, 16, v121
    v_and_b32 v39, s22, v121
    v_pk_mul_f32 v[72:73], v[36:37], v[112:113] op_sel:[0,0] op_sel_hi:[1,0]
    v_pk_mul_f32 v[74:75], v[38:39], v[112:113] op_sel:[0,0] op_sel_hi:[1,0]
    v_lshlrev_b32 v36, 16, v124
    v_and_b32 v37, s22, v124
    v_lshlrev_b32 v38, 16, v125
    v_and_b32 v39, s22, v125
    v_add_f32 v76, v112, v113
    v_pk_fma_f32 v[72:73], v[36:37], v[112:113], v[72:73] op_sel:[0,1,0] op_sel_hi:[1,1,1]
    v_pk_fma_f32 v[74:75], v[38:39], v[112:113], v[74:75] op_sel:[0,1,0] op_sel_hi:[1,1,1]
L_sum:
    v_mov_b32 v77, v76
    v_permlane32_swap_b32 v72, v73
    s_nop 0
    v_permlane32_swap_b32 v74, v75
    v_permlane32_swap_b32 v76, v77
    v_add_f32 v72, v72, v73
    v_add_f32 v76, v76, v77
    v_add_f32 v74, v74, v75
    v_mov_b32 v77, v76
    s_nop 0
    v_permlane16_swap_b32 v72, v74
    v_permlane16_swap_b32 v76, v77
    v_add_f32 v72, v72, v74
    v_add_f32 v76, v76, v77
    s_nop 0
    v_add_f32_dpp v72, v72, v72 row_ror:4 row_mask:0xf bank_mask:0xf
    v_add_f32_dpp v76, v76, v76 row_ror:4 row_mask:0xf bank_mask:0xf
    s_nop 0
    v_add_f32_dpp v72, v72, v72 row_ror:8 row_mask:0xf bank_mask:0xf
    v_add_f32_dpp v76, v76, v76 row_ror:8 row_mask:0xf bank_mask:0xf
    v_rcp_f32 v76, v76
    s_mov_b32 exec_lo, 0x000f000f
    s_mov_b32 exec_hi, 0x000f000f
    v_mul_f32 v72, v72, v76
    v_cvt_pk_bf16_f32 v72, v72, v72
    global_store_short v4, v72, s[20:21]
    s_cmp_lg_u32 s68, s76
    s_cbranch_scc1 L_noep
    s_mov_b64 exec, 1
    v_mov_b32 v2, s83
    v_mov_b32 v3, s80
    global_store_dword v2, v3, s[24:25]
L_noep:
    s_add_u32 s33, s33, s45
    s_cmp_lt_u32 s33, 16
    s_cbranch_scc1 L_task
L_exit:
    s_endpgm
L_task:
    s_mov_b64 exec, -1
    s_lshl_b32 s68, s33, 6
    s_add_u32 s68, s68, s46
    s_add_u32 s68, s68, s76
    s_add_u32 s69, s68, 0x10000
    s_add_u32 s70, s68, 0x20000
    s_add_u32 s71, s68, 0x30000
    s_and_b32 s72, s33, 3
    s_lshl_b32 s72, s72, 6
    s_and_b32 s43, s33, 12
    s_lshl_b32 s43, s43, 1
    s_add_u32 s72, s72, s43
    s_cmp_eq_u32 s73, 0
    s_mov_b32 s73, 1
    s_cbranch_scc1 L_taskback
    s_branch L_poll
L_pmore:
    buffer_load_dwordx4 v[128:131], v19, s[4:7], s70 offen sc1
    s_mov_b64 exec, s[66:67]
    s_cbranch_execz L_p3
    buffer_load_dwordx4 v[132:135], v19, s[4:7], s71 offen sc1
L_p3:
    s_mov_b64 exec, -1
    s_sub_i32 s75, s75, 1
    s_cbranch_scc0 L_chk4
L_late:
    s_mov_b32 s75, 0x80000000
    s_or_b32 s77, s77, 1
L_chk4:
    v_add_u32 v4, s72, v10
    s_waitcnt vmcnt(0) lgkmcnt(0)
    v_cmp_ne_u32 vcc, s51, v123
    v_cmp_ne_u32_e64 s[52:53], s51, v127
    v_cmp_ne_u32_e64 s[54:55], s51, v131
    v_cmp_ne_u32_e64 s[56:57], s51, v135
    v_max3_f32 v2, v122, v126, v130
    v_max_f32 v2, v2, v134
    s_or_b64 vcc, vcc, s[52:53]
    s_or_b64 vcc, vcc, s[54:55]
    s_or_b64 vcc, vcc, s[56:57]
    s_cbranch_vccz L_slow
    s_sub_u32 s47, s47, 1
    s_cbranch_scc1 L_slow
    s_cmp_eq_u32 s77, 0
    s_cbranch_scc1 L_poll
    s_cmp_eq_u32 s77, 3
    s_cbranch_scc1 L_tog
    s_mov_b32 s77, 3
    s_cmp_ge_u32 s28, 4
    s_cbranch_scc1 L_tog
    v_xor_b32 v139, s74, v139
    s_add_u32 s44, s44, 0x100000
    buffer_store_dwordx4 v[136:139], v9, s[24:27], s44 offen sc1
L_tog:
    s_xor_b32 s76, s76, 0x100000
    s_xor_b32 s68, s68, 0x100000
    s_xor_b32 s69, s69, 0x100000
    s_xor_b32 s70, s70, 0x100000
    s_xor_b32 s71, s71, 0x100000
    s_xor_b32 s51, s51, s74
    v_mov_b32 v123, s51
    v_mov_b32 v127, s51
    v_mov_b32 v131, s51
    v_mov_b32 v135, s51
    s_branch L_poll
L_slow:
    s_nop 0
    v_max_f32_dpp v2, v2, v2 row_ror:4 row_mask:0xf bank_mask:0xf
    s_nop 1
    v_max_f32_dpp v2, v2, v2 row_ror:8 row_mask:0xf bank_mask:0xf
    v_mov_b32 v3, v2
    s_nop 1
    v_permlane16_swap_b32 v2, v3
    v_max_f32 v2, v2, v3
    v_mov_b32 v3, v2
    s_nop 1
    v_permlane32_swap_b32 v2, v3
    v_max_f32 v148, v2, v3
    s_cmp_eq_u64 s[64:65], 0
    s_cbranch_scc1 L_got
    v_sub_f32 v112, v122, v148
    v_sub_f32 v113, v126, v148
    v_sub_f32 v114, v130, v148
    v_sub_f32 v115, v134, v148
    v_exp_f32 v112, v112
    v_exp_f32 v113, v113
    v_exp_f32 v114, v114
    v_exp_f32 v115, v115
    v_lshlrev_b32 v36, 16, v120
    v_and_b32 v37, s22, v120
    v_lshlrev_b32 v38, 16, v121
    v_and_b32 v39, s22, v121
    v_pk_mul_f32 v[72:73], v[36:37], v[112:113] op_sel:[0,0] op_sel_hi:[1,0]
    v_pk_mul_f32 v[74:75], v[38:39], v[112:113] op_sel:[0,0] op_sel_hi:[1,0]
    v_lshlrev_b32 v36, 16, v124
    v_and_b32 v37, s22, v124
    v_lshlrev_b32 v38, 16, v125
    v_and_b32 v39, s22, v125
    v_add_f32 v76, v112, v113
    v_pk_fma_f32 v[72:73], v[36:37], v[112:113], v[72:73] op_sel:[0,1,0] op_sel_hi:[1,1,1]
    v_pk_fma_f32 v[74:75], v[38:39], v[112:113], v[74:75] op_sel:[0,1,0] op_sel_hi:[1,1,1]
    v_lshlrev_b32 v36, 16, v128
    v_and_b32 v37, s22, v128
    v_lshlrev_b32 v38, 16, v129
    v_and_b32 v39, s22, v129
    v_add_f32 v76, v76, v114
    v_pk_fma_f32 v[72:73], v[36:37], v[114:115], v[72:73] op_sel:[0,0,0] op_sel_hi:[1,0,1]
    v_pk_fma_f32 v[74:75], v[38:39], v[114:115], v[74:75] op_sel:[0,0,0] op_sel_hi:[1,0,1]
    v_lshlrev_b32 v36, 16, v132
    v_and_b32 v37, s22, v132
    v_lshlrev_b32 v38, 16, v133
    v_and_b32 v39, s22, v133
    v_add_f32 v76, v76, v115
    v_pk_fma_f32 v[72:73], v[36:37], v[114:115], v[72:73] op_sel:[0,1,0] op_sel_hi:[1,1,1]
    v_pk_fma_f32 v[74:75], v[38:39], v[114:115], v[74:75] op_sel:[0,1,0] op_sel_hi:[1,1,1]
    s_branch L_sum
L_general:
    s_mov_b64 s[12:13], s[60:61]
    s_mov_b32 s14, s10
    s_mov_b32 s15, 0x20000
    v_mov_b32 v56, 0
    v_mov_b32 v57, 0
    v_mov_b32 v58, 0
    v_mov_b32 v59, 0
    s_lshl_b32 s42, s28, 10
    s_and_b32 s42, s42, 0xfff
    s_add_u32 s42, s42, 131072
    s_mov_b32 m0, s42
    v_mov_b32 v3, v9
    v_add_u32 v7, 1, v1
    s_mov_b32 s43, 0x42700000
    s_waitcnt vmcnt(0)
    global_load_lds_dwordx4 v3, s[62:63]
    v_mov_b32 v2, s52
    v_writelane_b32 v2, s55, 1
    v_writelane_b32 v2, s53, 2
    v_writelane_b32 v2, s54, 3
    v_add_u32 v3, -1, v2
    v_ashrrev_i32 v3, 4, v3
    v_min_u32 v3, 0xff, v3
    v_add_u32 v3, 1, v3
    s_nop 1
    v_add_u32_dpp v5, v3, v3 row_shr:1 row_mask:0xf bank_mask:0xf bound_ctrl:0
    v_lshlrev_b32 v3, 1, v3
    v_cvt_f32_u32 v14, v3
    v_add_u32_dpp v5, v5, v5 row_shr:2 row_mask:0xf bank_mask:0xf bound_ctrl:0
    s_nop 1
    v_cvt_f32_u32_dpp v8, v5 quad_perm:[3,3,3,3] row_mask:0xf bank_mask:0xf
    v_cvt_f32_u32 v5, v5
    v_rcp_f32 v8, v8
    v_mul_f32 v5, s43, v5
    v_fma_f32 v8, v5, v8, 0.5
    v_cvt_u32_f32 v8, v8
    v_add_u32 v8, v8, v7
    v_cmp_ge_u32 vcc, s29, v8
    s_nop 0
    v_mov_b32_dpp v19, v8 row_shr:1 row_mask:0xf bank_mask:0xf bound_ctrl:0
    s_and_b32 s32, vcc_lo, 7
    v_sub_u32 v15, v8, v19
    v_sub_u32 v10, s29, v19
    v_cvt_f32_u32 v12, v15
    v_rcp_f32 v12, v12
    v_add_u32 v5, 1, v10
    v_mul_f32 v14, v14, v12
    v_cvt_f32_u32 v12, v10
    v_cvt_f32_u32 v13, v5
    v_cmp_eq_u32 vcc, v5, v15
    v_mul_f32 v12, v12, v14
    v_mul_f32 v13, v13, v14
    v_cvt_u32_f32 v12, v12
    v_cvt_u32_f32 v13, v13
    s_bcnt1_i32_b32 s32, s32
    v_cndmask_b32 v13, v13, v3, vcc
    v_readlane_b32 s48, v12, s32
    v_readlane_b32 s35, v2, s32
    v_readlane_b32 s49, v13, s32
    v_readlane_b32 s33, v19, s32
    v_readlane_b32 s34, v15, s32
    s_lshl_b32 s32, s32, 3
    s_lshr_b32 s32, 0x2010300, s32
    s_and_b32 s32, s32, 3
    s_xor_b32 s42, s48, s28
    s_and_b32 s42, s42, 1
    s_add_u32 s48, s48, s42
    s_andn2_b32 s42, s28, 1
    s_add_u32 s48, s48, s42
    s_sub_i32 s36, s49, s48
    s_lshr_b32 s48, s48, 1
    s_lshl_b32 s42, s32, 8
    s_add_u32 s42, s42, s48
    s_lshl_b32 s42, s42, 2
    s_add_u32 s42, s42, 131072
    v_lshl_add_u32 v2, v1, 4, s42
    s_waitcnt vmcnt(0)
    s_barrier
    ds_read_b32 v8, v2
    s_cmp_gt_i32 s35, 0
    s_cselect_b32 s49, 0xdd800000, 0
    s_add_i32 s36, s36, 7
    s_ashr_i32 s36, s36, 3
    s_lshl_b32 s48, s48, 4
    s_sub_i32 s35, s35, s48
    s_lshl_b32 s50, s32, 13
    s_lshl_b32 s42, s31, 2
    s_add_u32 s42, s42, s50
    v_lshl_add_u32 v11, v1, 4, s42
    s_mov_b32 m0, s38
    s_mov_b32 s73, 1
    s_waitcnt lgkmcnt(0)
    s_cmp_lt_i32 s36, 1
    s_cbranch_scc1 L_issued
    s_branch L_have
L_fin:
L_end:
    s_endpgm
.section .rodata,"a"
.p2align 6
.amdhsa_kernel standalone__paged_block_table_kv_pagedattention__decode_kernel
  .amdhsa_next_free_vgpr 152
  .amdhsa_next_free_sgpr 102
  .amdhsa_accum_offset 152
  .amdhsa_group_segment_fixed_size 0
  .amdhsa_kernarg_size 64
  .amdhsa_user_sgpr_count 2
  .amdhsa_user_sgpr_kernarg_segment_ptr 1
  .amdhsa_system_sgpr_workgroup_id_x 1
.end_amdhsa_kernel
```
